```python
import torch

def _softmax(x, axis=-1):
    return torch.softmax(x, dim=axis)
def _gelu(x):
    return torch.nn.functional.gelu(x, approximate="tanh")
def _silu(x):
    return torch.nn.functional.silu(x)
def _sigmoid(x):
    return torch.sigmoid(x)
def _layernorm(x, axis=-1, eps=1e-5):
    m = x.mean(dim=axis, keepdim=True)
    v = x.var(dim=axis, keepdim=True, unbiased=False)
    return (x - m) / torch.sqrt(v + eps)
def _scatter_add(tgt, idx, src, axis=0):
    return tgt.clone().index_add_(axis, idx, src)
def _segment_sum(src, seg, n):
    out = torch.zeros((n,) + src.shape[1:], dtype=src.dtype)
    return out.index_add_(0, seg, src)
def _pad(x, pw):
    flat = tuple(v for pair in reversed(pw) for v in pair)
    return torch.nn.functional.pad(x, flat)

kernel_name = 'standalone__paged_block_table_kv_radixattention__sampling'

def setup_inputs():

    _w = (lambda a: (lambda t: t.to(torch.bfloat16) if t.is_floating_point() else t)(torch.as_tensor(a)))
    B, H, Hkv, Dh = 8, 32, 8, 128
    Lk = 8192
    bs = 16
    nb = max(2, Lk // bs)
    P = max(1, nb // 2)
    n_phys = P + B * (nb - P)
    shared = torch.arange(P, dtype=torch.int64)
    priv = P + torch.arange(B * (nb - P), dtype=torch.int64).reshape(B, nb - P)
    bt = torch.cat([torch.tile(shared[None, :], (B, 1)), priv], dim=1)
    ctx = nb * bs - (torch.arange(1, B + 1, dtype=torch.int64) * 2654435761) % max(1, (nb * bs - P * bs) // 2)
    return {
        "q": _w((lambda *s: torch.randn(*s, dtype=torch.bfloat16) * 0.8)(B, H, Dh)),
        "k_cache": _w((lambda *s: torch.randn(*s, dtype=torch.bfloat16) * 0.8)(n_phys, bs, Hkv, Dh)),
        "v_cache": _w((lambda *s: torch.randn(*s, dtype=torch.bfloat16) * 0.05)(n_phys, bs, Hkv, Dh)),
        "block_table": _w(bt.to(torch.int64)),
        "ctx_lens": _w(torch.as_tensor(ctx).to(torch.int64)),
    }

def reference(q, k_cache, v_cache, block_table, ctx_lens):
    B, H, Dh = q.shape
    n_phys, bs, Hkv, _ = k_cache.shape
    nb = block_table.shape[1]
    Lk = nb * bs
    rep = H // Hkv
    k = k_cache[block_table].reshape(B, Lk, Hkv, Dh)
    v = v_cache[block_table].reshape(B, Lk, Hkv, Dh)
    k = (lambda x, n, axis: torch.repeat_interleave(x, n, dim=axis))(k, rep, axis=2)
    v = (lambda x, n, axis: torch.repeat_interleave(x, n, dim=axis))(v, rep, axis=2)
    scores = torch.einsum("bhd,bkhd->bhk", q, k) * (Dh ** -0.5)
    pos = torch.arange(Lk)
    valid = pos[None, :] < ctx_lens[:, None]
    scores = torch.where(valid[:, None, :], scores, -1e9)
    p = _softmax(scores, axis=-1)
    return torch.einsum("bhk,bkhd->bhd", p, v)
```

```asm
; @launch grid=(256,1,1) block=(512,1,1) lds=149632
.amdgcn_target "amdgcn-amd-amdhsa--gfx950"
.text
.globl standalone__paged_block_table_kv_radixattention__sampling_kernel
.p2align 8
.type standalone__paged_block_table_kv_radixattention__sampling_kernel,@function
standalone__paged_block_table_kv_radixattention__sampling_kernel:
    s_load_dwordx16 s[4:19], s[0:1], 0
    s_cmp_ge_u32 s2, 256
    s_cbranch_scc1 L_end
    v_lshrrev_b32 v224, 6, v0
    v_and_b32 v222, 63, v0
    s_mov_b32 s33, 0
    v_readfirstlane_b32 s44, v224
    s_mov_b32 s34, 0
    s_mov_b32 s70, 1156116
    s_movk_i32 s73, 3
    s_cmpk_ge_u32 s2, 29
    s_cmovk_i32 s33, 1
    s_cmovk_i32 s34, 29
    s_cselect_b32 s70, 838861, s70
    s_cmovk_i32 s73, -3
    s_cmpk_ge_u32 s2, 69
    s_cmovk_i32 s33, 2
    s_cmovk_i32 s34, 69
    s_cselect_b32 s70, 1157986, s70
    s_cmpk_ge_u32 s2, 98
    s_cmovk_i32 s33, 3
    s_cmovk_i32 s34, 98
    s_cselect_b32 s70, 1156116, s70
    s_cmovk_i32 s73, 3
    s_cmpk_ge_u32 s2, 127
    s_cmovk_i32 s33, 4
    s_cmovk_i32 s34, 127
    s_cselect_b32 s70, 1157986, s70
    s_cmovk_i32 s73, -3
    s_cmpk_ge_u32 s2, 156
    s_cmovk_i32 s33, 5
    s_cmovk_i32 s34, 156
    s_cselect_b32 s70, 838861, s70
    s_cmovk_i32 s73, 3
    s_cmpk_ge_u32 s2, 196
    s_cmovk_i32 s33, 6
    s_cmovk_i32 s34, 196
    s_cselect_b32 s70, 1156116, s70
    s_cmpk_ge_u32 s2, 225
    s_cmovk_i32 s33, 7
    s_cmovk_i32 s34, 225
    s_cselect_b32 s70, 1083220, s70
    s_cmovk_i32 s73, -3
    s_sub_u32 s34, s2, s34
    s_and_b32 s32, s44, 3
    v_mov_b32 v217, 149504
    s_lshl_b32 s45, s33, 8
    s_cmp_eq_u32 s44, 4
    s_cbranch_scc1 L_loader
    v_lshlrev_b32 v5, 2, v222
    v_and_b32 v5, 0x7c, v5
    v_add_u32 v5, 149504, v5
    v_mov_b32 v7, 0
    ds_write_b32 v5, v7
    v_lshlrev_b32 v3, 3, v0
    v_add_u32 v1, 0x1000, v3
    v_add_u32 v2, 0x3000, v3
    v_and_b32 v4, 0x1c, v222
    s_cmp_lt_u32 s44, 4
    s_waitcnt lgkmcnt(0)
    s_cbranch_scc1 L_cbt
    s_barrier
    s_sleep 40
    s_branch L_helper
L_cbt:
    s_barrier
    s_setprio 3
    global_load_dwordx2 v[72:73], v1, s[10:11] offset:-4096
    global_load_dwordx2 v[74:75], v1, s[10:11] offset:-2048
    global_load_dwordx2 v[76:77], v1, s[10:11] offset:0
    global_load_dwordx2 v[78:79], v1, s[10:11] offset:2048
    global_load_dwordx2 v[80:81], v2, s[10:11] offset:-4096
    global_load_dwordx2 v[82:83], v2, s[10:11] offset:-2048
    global_load_dwordx2 v[84:85], v2, s[10:11] offset:0
    global_load_dwordx2 v[86:87], v2, s[10:11] offset:2048
    global_load_dword v215, v4, s[12:13]
    s_branch L_cpre
L_loader:
    s_setprio 2
    s_add_u32 s82, s34, 0
    s_and_b32 s43, s82, 1
    s_mul_i32 s43, s43, s73
    s_lshl_b32 s82, s82, 7
    s_add_u32 s82, s82, s43
    s_mul_i32 s82, s82, 29760
    s_mul_hi_u32 s82, s82, s70
    s_mul_i32 s43, s82, 15421
    s_lshr_b32 s43, s43, 18
    s_sub_i32 s82, s82, 256
    s_ashr_i32 s82, s82, 4
    s_max_i32 s82, s82, s43
    s_mov_b32 s84, 0
    s_movk_i32 s85, 485
    s_movk_i32 s86, 27
    s_cmpk_ge_u32 s82, 485
    s_cmovk_i32 s84, 27
    s_cmovk_i32 s85, 687
    s_cmovk_i32 s86, 81
    s_cmpk_ge_u32 s82, 687
    s_cmovk_i32 s84, 81
    s_cmovk_i32 s85, 862
    s_cmovk_i32 s86, 162
    s_cmpk_ge_u32 s82, 862
    s_cmovk_i32 s84, 162
    s_cmovk_i32 s85, 1010
    s_cmovk_i32 s86, 270
    s_cmpk_ge_u32 s82, 1010
    s_cmovk_i32 s84, 270
    s_cmovk_i32 s85, 1259
    s_cmovk_i32 s86, 277
    s_cmpk_ge_u32 s82, 1259
    s_cmovk_i32 s84, 277
    s_cmovk_i32 s85, 1481
    s_cmovk_i32 s86, 311
    s_cmpk_ge_u32 s82, 1481
    s_cmovk_i32 s84, 311
    s_cmovk_i32 s85, 1676
    s_cmovk_i32 s86, 372
    s_cmpk_ge_u32 s82, 1676
    s_cmovk_i32 s84, 372
    s_cmovk_i32 s85, 1844
    s_cmovk_i32 s86, 460
    v_lshlrev_b32 v10, 1, v222
    v_add_u32 v8, s82, v10
    v_cmp_le_u32 vcc, s85, v8
    v_mov_b32 v228, s84
    v_mov_b32 v229, s86
    v_cndmask_b32 v228, v228, v229, vcc
    v_add_u32 v8, v8, v228
    v_lshlrev_b32 v8, 15, v8
    v_add_u32 v8, s45, v8
    v_add_u32 v10, 1, v10
    v_add_u32 v9, s82, v10
    v_cmp_le_u32 vcc, s85, v9
    v_mov_b32 v228, s84
    v_mov_b32 v229, s86
    v_cndmask_b32 v228, v228, v229, vcc
    v_add_u32 v9, v9, v228
    v_lshlrev_b32 v9, 15, v9
    v_add_u32 v9, s45, v9
    v_lshrrev_b32 v224, 4, v222
    v_and_b32 v225, 15, v222
    v_xor_b32 v226, v225, v224
    v_lshlrev_b32 v226, 4, v226
    v_lshl_add_u32 v12, v224, 11, v226
    v_xor_b32 v13, 64, v12
    v_add_u32 v13, 7168, v13
    v_xor_b32 v14, 128, v12
    v_add_u32 v14, 14336, v14
    v_xor_b32 v15, 192, v12
    v_add_u32 v15, 21504, v15
    s_mov_b32 s22, 75497472
    s_mov_b32 s23, 0x20000
    v_readlane_b32 s49, v8, 0
    v_readlane_b32 s50, v9, 0
    s_mov_b32 s40, 0
    s_waitcnt lgkmcnt(0)
    s_mov_b32 s20, s6
    s_mov_b32 s21, s7
    s_mov_b32 m0, s40
    s_nop 0
    buffer_load_dwordx4 v12, s[20:23], s49 offen offset:0 nt lds
    buffer_load_dwordx4 v13, s[20:23], s49 offen offset:1024 nt lds
    buffer_load_dwordx4 v14, s[20:23], s49 offen offset:2048 nt lds
    buffer_load_dwordx4 v15, s[20:23], s49 offen offset:3072 nt lds
    s_add_u32 m0, s40, 4096
    s_nop 0
    buffer_load_dwordx4 v12, s[20:23], s50 offen offset:0 nt lds
    buffer_load_dwordx4 v13, s[20:23], s50 offen offset:1024 nt lds
    buffer_load_dwordx4 v14, s[20:23], s50 offen offset:2048 nt lds
    buffer_load_dwordx4 v15, s[20:23], s50 offen offset:3072 nt lds
    v_readlane_b32 s49, v8, 1
    v_readlane_b32 s50, v9, 1
    s_add_u32 s40, s40, 32768
    s_nop 1
    s_mov_b32 m0, s40
    s_nop 0
    buffer_load_dwordx4 v12, s[20:23], s49 offen offset:0 nt lds
    buffer_load_dwordx4 v13, s[20:23], s49 offen offset:1024 nt lds
    buffer_load_dwordx4 v14, s[20:23], s49 offen offset:2048 nt lds
    buffer_load_dwordx4 v15, s[20:23], s49 offen offset:3072 nt lds
    s_add_u32 m0, s40, 4096
    s_nop 0
    buffer_load_dwordx4 v12, s[20:23], s50 offen offset:0 nt lds
    buffer_load_dwordx4 v13, s[20:23], s50 offen offset:1024 nt lds
    buffer_load_dwordx4 v14, s[20:23], s50 offen offset:2048 nt lds
    buffer_load_dwordx4 v15, s[20:23], s50 offen offset:3072 nt lds
    v_readlane_b32 s49, v8, 2
    v_readlane_b32 s50, v9, 2
    s_add_u32 s40, s40, 32768
    s_nop 1
    s_barrier
    s_mov_b32 m0, s40
    s_nop 0
    buffer_load_dwordx4 v12, s[20:23], s49 offen offset:0 nt lds
    buffer_load_dwordx4 v13, s[20:23], s49 offen offset:1024 nt lds
    buffer_load_dwordx4 v14, s[20:23], s49 offen offset:2048 nt lds
    buffer_load_dwordx4 v15, s[20:23], s49 offen offset:3072 nt lds
    s_add_u32 m0, s40, 4096
    s_nop 0
    buffer_load_dwordx4 v12, s[20:23], s50 offen offset:0 nt lds
    buffer_load_dwordx4 v13, s[20:23], s50 offen offset:1024 nt lds
    buffer_load_dwordx4 v14, s[20:23], s50 offen offset:2048 nt lds
    buffer_load_dwordx4 v15, s[20:23], s50 offen offset:3072 nt lds
    v_readlane_b32 s49, v8, 3
    v_readlane_b32 s50, v9, 3
    s_add_u32 s40, s40, 32768
    s_nop 1
    s_mov_b32 m0, s40
    s_nop 0
    buffer_load_dwordx4 v12, s[20:23], s49 offen offset:0 nt lds
    buffer_load_dwordx4 v13, s[20:23], s49 offen offset:1024 nt lds
    buffer_load_dwordx4 v14, s[20:23], s49 offen offset:2048 nt lds
    buffer_load_dwordx4 v15, s[20:23], s49 offen offset:3072 nt lds
    s_add_u32 m0, s40, 4096
    s_nop 0
    buffer_load_dwordx4 v12, s[20:23], s50 offen offset:0 nt lds
    buffer_load_dwordx4 v13, s[20:23], s50 offen offset:1024 nt lds
    buffer_load_dwordx4 v14, s[20:23], s50 offen offset:2048 nt lds
    buffer_load_dwordx4 v15, s[20:23], s50 offen offset:3072 nt lds
    v_lshlrev_b32 v226, 2, v224
    v_xor_b32 v226, v225, v226
    v_lshlrev_b32 v226, 4, v226
    v_lshl_add_u32 v16, v224, 11, v226
    v_add_u32 v17, 7168, v16
    v_add_u32 v18, 14336, v16
    v_add_u32 v19, 21504, v16
    s_mov_b32 s24, s8
    s_mov_b32 s25, s9
    s_mov_b32 s26, 75497472
    s_mov_b32 s27, 0x20000
    s_add_u32 s83, s34, 1
    s_and_b32 s43, s83, 1
    s_mul_i32 s43, s43, s73
    s_lshl_b32 s83, s83, 7
    s_add_u32 s83, s83, s43
    s_mul_i32 s83, s83, 29760
    s_mul_hi_u32 s83, s83, s70
    s_mul_i32 s43, s83, 15421
    s_lshr_b32 s43, s43, 18
    s_sub_i32 s83, s83, 256
    s_ashr_i32 s83, s83, 4
    s_max_i32 s83, s83, s43
    s_sub_u32 s83, s83, s82
    v_cmp_gt_u32 vcc, s83, v10
    v_mov_b32 v229, 0x7fff0000
    s_add_u32 s79, s83, 1
    v_cndmask_b32 v9, v229, v9, vcc
    s_lshr_b32 s79, s79, 1
    v_add_u32 v218, 72, v217
    v_and_b32 v22, 3, v222
    v_lshl_add_u32 v22, v22, 2, v217
    v_mov_b32 v20, 0
    v_mov_b32 v21, 0
    s_mov_b32 s88, 0
    s_mov_b32 s76, 1
    s_mov_b32 s89, 0
    s_mov_b32 s75, -2
L_lround:
    s_sub_i32 s87, s76, 0
    s_cmp_lt_i32 s87, 0
    s_cbranch_scc1 L_lk_nx
    s_lshl_b32 s72, s87, 2
    s_sub_i32 s78, s79, s72
    s_cmp_lt_i32 s78, 1
    s_cbranch_scc1 L_lk_nx
    s_min_u32 s78, s78, 4
    s_and_b32 s40, s87, 1
    s_lshl_b32 s40, s40, 14
    s_sub_i32 s87, s87, 1
    s_mov_b32 s77, 0
L_lk_w:
    v_readlane_b32 s42, v20, s77
    s_add_u32 s43, s72, s77
    s_cmp_lt_u32 s43, 64
    s_cbranch_scc0 L_lk_hi
    v_readlane_b32 s49, v8, s43
    v_readlane_b32 s50, v9, s43
L_lk_lo:
    s_cmp_ge_i32 s42, s87
    s_cbranch_scc1 L_lk_go
    s_mov_b32 s71, 0
L_lk_chk:
    ds_read_b32 v20, v22 offset:48
    ds_read_b32 v24, v217 offset:68
    s_add_u32 s71, s71, 1
    s_waitcnt lgkmcnt(0)
    v_readlane_b32 s42, v20, s77
    v_readfirstlane_b32 s43, v24
    s_cmp_ge_i32 s42, s87
    s_cbranch_scc1 L_lk_go
    s_cmp_gt_u32 s71, 0x100000
    s_cbranch_scc1 L_end
    s_andn2_b32 s43, s43, s88
    s_cmp_gt_u32 s43, 0x103
    s_cbranch_scc0 L_lk_chk
    s_and_b32 s43, s43, 0xff
    s_cmp_lt_u32 s43, 4
    s_cbranch_scc1 L_lk_chk
    s_branch L_restart
L_lk_hi:
    v_readlane_b32 s49, v10, s43
    v_readlane_b32 s50, v11, s43
    s_branch L_lk_lo
L_lk_go:
    s_add_i32 s75, s75, 1
    s_add_u32 s77, s77, 1
    s_max_i32 s42, s75, 0
    s_mov_b32 m0, s40
    s_nop 0
    buffer_load_dwordx4 v12, s[20:23], s49 offen offset:0 nt lds
    buffer_load_dwordx4 v13, s[20:23], s49 offen offset:1024 nt lds
    buffer_load_dwordx4 v14, s[20:23], s49 offen offset:2048 nt lds
    buffer_load_dwordx4 v15, s[20:23], s49 offen offset:3072 nt lds
    s_add_u32 m0, s40, 4096
    s_nop 0
    buffer_load_dwordx4 v12, s[20:23], s50 offen offset:0 nt lds
    buffer_load_dwordx4 v13, s[20:23], s50 offen offset:1024 nt lds
    buffer_load_dwordx4 v14, s[20:23], s50 offen offset:2048 nt lds
    buffer_load_dwordx4 v15, s[20:23], s50 offen offset:3072 nt lds
    v_mov_b32 v224, s42
    s_add_u32 s40, s40, 32768
    s_waitcnt vmcnt(48)
    ds_write_b32 v218, v224
    s_cmp_lt_u32 s77, s78
    s_cbranch_scc1 L_lk_w
    ds_read_b32 v21, v22 offset:112
    s_waitcnt lgkmcnt(0)
L_lk_nx:
    s_sub_i32 s87, s76, 1
    s_cmp_lt_i32 s87, 0
    s_cbranch_scc1 L_lv_nx
    s_lshl_b32 s72, s87, 2
    s_sub_i32 s78, s79, s72
    s_cmp_lt_i32 s78, 1
    s_cbranch_scc1 L_lv_nx
    s_min_u32 s78, s78, 4
    s_and_b32 s40, s87, 1
    s_lshl_b32 s40, s40, 14
    s_add_u32 s40, s40, 8192
    s_sub_i32 s87, s87, 1
    s_mov_b32 s77, 0
L_lv_w:
    v_readlane_b32 s42, v21, s77
    s_add_u32 s43, s72, s77
    s_cmp_lt_u32 s43, 64
    s_cbranch_scc0 L_lv_hi
    v_readlane_b32 s49, v8, s43
    v_readlane_b32 s50, v9, s43
L_lv_lo:
    s_cmp_ge_i32 s42, s87
    s_cbranch_scc1 L_lv_go
    s_mov_b32 s71, 0
L_lv_chk:
    ds_read_b32 v21, v22 offset:112
    ds_read_b32 v24, v217 offset:68
    s_add_u32 s71, s71, 1
    s_waitcnt lgkmcnt(0)
    v_readlane_b32 s42, v21, s77
    v_readfirstlane_b32 s43, v24
    s_cmp_ge_i32 s42, s87
    s_cbranch_scc1 L_lv_go
    s_cmp_gt_u32 s71, 0x100000
    s_cbranch_scc1 L_end
    s_andn2_b32 s43, s43, s88
    s_cmp_gt_u32 s43, 0x103
    s_cbranch_scc0 L_lv_chk
    s_and_b32 s43, s43, 0xff
    s_cmp_lt_u32 s43, 4
    s_cbranch_scc1 L_lv_chk
    s_branch L_restart
L_lv_hi:
    v_readlane_b32 s49, v10, s43
    v_readlane_b32 s50, v11, s43
    s_branch L_lv_lo
L_lv_go:
    s_add_i32 s75, s75, 1
    s_add_u32 s77, s77, 1
    s_max_i32 s42, s75, 0
    s_mov_b32 m0, s40
    s_nop 0
    buffer_load_dwordx4 v16, s[24:27], s49 offen offset:0 nt lds
    buffer_load_dwordx4 v17, s[24:27], s49 offen offset:1024 nt lds
    buffer_load_dwordx4 v18, s[24:27], s49 offen offset:2048 nt lds
    buffer_load_dwordx4 v19, s[24:27], s49 offen offset:3072 nt lds
    s_add_u32 m0, s40, 4096
    s_nop 0
    buffer_load_dwordx4 v16, s[24:27], s50 offen offset:0 nt lds
    buffer_load_dwordx4 v17, s[24:27], s50 offen offset:1024 nt lds
    buffer_load_dwordx4 v18, s[24:27], s50 offen offset:2048 nt lds
    buffer_load_dwordx4 v19, s[24:27], s50 offen offset:3072 nt lds
    v_mov_b32 v224, s42
    s_add_u32 s40, s40, 32768
    s_waitcnt vmcnt(48)
    ds_write_b32 v218, v224
    s_cmp_lt_u32 s77, s78
    s_cbranch_scc1 L_lv_w
    ds_read_b32 v20, v22 offset:48
    s_waitcnt lgkmcnt(0)
L_lv_nx:
    s_lshl_b32 s42, s76, 2
    s_add_u32 s76, s76, 1
    s_cmp_lt_u32 s42, s79
    s_cbranch_scc1 L_lround
    s_add_i32 s75, s75, 1
    s_max_i32 s42, s75, 0
    v_mov_b32 v224, s42
    s_waitcnt vmcnt(40)
    ds_write_b32 v218, v224
    s_add_i32 s75, s75, 1
    s_max_i32 s42, s75, 0
    v_mov_b32 v224, s42
    s_waitcnt vmcnt(32)
    ds_write_b32 v218, v224
    s_add_i32 s75, s75, 1
    s_max_i32 s42, s75, 0
    v_mov_b32 v224, s42
    s_waitcnt vmcnt(24)
    ds_write_b32 v218, v224
    s_add_i32 s75, s75, 1
    s_max_i32 s42, s75, 0
    v_mov_b32 v224, s42
    s_waitcnt vmcnt(16)
    ds_write_b32 v218, v224
    s_add_i32 s75, s75, 1
    s_max_i32 s42, s75, 0
    v_mov_b32 v224, s42
    s_waitcnt vmcnt(8)
    ds_write_b32 v218, v224
    s_add_i32 s75, s75, 1
    s_max_i32 s42, s75, 0
    v_mov_b32 v224, s42
    s_waitcnt vmcnt(0)
    ds_write_b32 v218, v224
    s_branch L_helper
L_restart:
    v_lshlrev_b32 v225, 3, v222
    v_add_u32 v225, 147456, v225
    ds_read_b64 v[8:9], v225
    ds_read_b64 v[10:11], v225 offset:512
    ds_read_b32 v24, v217 offset:80
    v_add_u32 v218, 76, v217
    v_mov_b32 v224, 0x10000
    s_mov_b32 s88, -1
    s_mov_b32 s76, 0
    s_mov_b32 s75, -6
    s_waitcnt vmcnt(0) lgkmcnt(0)
    v_readfirstlane_b32 s79, v24
    s_mov_b64 exec, 1
    ds_add_u32 v217, v224 offset:68
    s_mov_b64 exec, -1
    s_add_u32 s79, s79, 1
    s_lshr_b32 s79, s79, 1
    s_branch L_lround
L_cpre:
    v_add_u32 v7, 131072, v3
    s_add_u32 s82, s34, 0
    s_and_b32 s43, s82, 1
    s_mul_i32 s43, s43, s73
    s_lshl_b32 s82, s82, 7
    s_add_u32 s82, s82, s43
    s_mul_i32 s82, s82, 29760
    s_mul_hi_u32 s82, s82, s70
    s_mul_i32 s43, s82, 15421
    s_lshr_b32 s43, s43, 18
    s_sub_i32 s82, s82, 256
    s_ashr_i32 s82, s82, 4
    s_max_i32 s82, s82, s43
    s_mov_b32 s84, 0
    s_movk_i32 s85, 485
    s_movk_i32 s86, 27
    s_cmpk_ge_u32 s82, 485
    s_cmovk_i32 s84, 27
    s_cmovk_i32 s85, 687
    s_cmovk_i32 s86, 81
    s_cmpk_ge_u32 s82, 687
    s_cmovk_i32 s84, 81
    s_cmovk_i32 s85, 862
    s_cmovk_i32 s86, 162
    s_cmpk_ge_u32 s82, 862
    s_cmovk_i32 s84, 162
    s_cmovk_i32 s85, 1010
    s_cmovk_i32 s86, 270
    s_cmpk_ge_u32 s82, 1010
    s_cmovk_i32 s84, 270
    s_cmovk_i32 s85, 1259
    s_cmovk_i32 s86, 277
    s_cmpk_ge_u32 s82, 1259
    s_cmovk_i32 s84, 277
    s_cmovk_i32 s85, 1481
    s_cmovk_i32 s86, 311
    s_cmpk_ge_u32 s82, 1481
    s_cmovk_i32 s84, 311
    s_cmovk_i32 s85, 1676
    s_cmovk_i32 s86, 372
    s_cmpk_ge_u32 s82, 1676
    s_cmovk_i32 s84, 372
    s_cmovk_i32 s85, 1844
    s_cmovk_i32 s86, 460
    s_add_u32 s42, s82, s84
    s_lshr_b32 s42, s42, 8
    s_lshl_b32 s43, s42, 2
    s_sub_u32 s43, s43, 4
    s_lshl_b32 s80, 0xff, s43
    s_cmp_eq_u32 s42, 0
    s_cselect_b32 s80, -1, s80
    s_mov_b32 s81, s80
    v_lshlrev_b32 v5, 11, v4
    v_and_b32 v6, 3, v222
    v_lshl_add_u32 v5, v6, 8, v5
    v_lshrrev_b32 v3, 5, v222
    v_lshl_add_u32 v5, v3, 4, v5
    s_lshl_b32 s42, s33, 10
    v_add_u32 v5, s42, v5
    v_mov_b32 v8, 0
    v_mov_b32 v9, 0
    v_mov_b32 v10, 0
    v_mov_b32 v11, 0
    v_mov_b32 v12, 0
    v_mov_b32 v13, 0
    v_mov_b32 v14, 0
    v_mov_b32 v15, 0
    v_mov_b32 v16, 0
    v_mov_b32 v17, 0
    v_mov_b32 v18, 0
    v_mov_b32 v19, 0
    v_mov_b32 v20, 0
    v_mov_b32 v21, 0
    v_mov_b32 v22, 0
    v_mov_b32 v23, 0
    v_mov_b32 v24, 0
    v_mov_b32 v25, 0
    v_mov_b32 v26, 0
    v_mov_b32 v27, 0
    v_mov_b32 v28, 0
    v_mov_b32 v29, 0
    v_mov_b32 v30, 0
    v_mov_b32 v31, 0
    v_mov_b32 v32, 0
    v_mov_b32 v33, 0
    v_mov_b32 v34, 0
    v_mov_b32 v35, 0
    v_mov_b32 v36, 0
    v_mov_b32 v37, 0
    v_mov_b32 v38, 0
    v_mov_b32 v39, 0
    s_mov_b64 exec, s[80:81]
    global_load_dwordx4 v[8:11], v5, s[4:5] offset:0
    global_load_dwordx4 v[12:15], v5, s[4:5] offset:32
    global_load_dwordx4 v[16:19], v5, s[4:5] offset:64
    global_load_dwordx4 v[20:23], v5, s[4:5] offset:96
    global_load_dwordx4 v[24:27], v5, s[4:5] offset:128
    global_load_dwordx4 v[28:31], v5, s[4:5] offset:160
    global_load_dwordx4 v[32:35], v5, s[4:5] offset:192
    global_load_dwordx4 v[36:39], v5, s[4:5] offset:224
    s_mov_b64 exec, -1
    s_setprio 1
    s_mov_b32 s28, s18
    s_mov_b32 s29, s19
    s_mov_b32 s30, 11534336
    s_mov_b32 s31, 0x20000
    s_lshl_b32 s40, s32, 15
    v_lshrrev_b32 v247, 1, v222
    v_and_b32 v230, 1, v222
    v_lshl_add_u32 v247, v247, 3, v230
    s_lshl_b32 s42, s32, 1
    v_add_u32 v247, s42, v247
    v_add_u32 v230, s34, v230
    s_add_u32 s83, s34, 1
    s_and_b32 s43, s83, 1
    s_mul_i32 s43, s43, s73
    s_lshl_b32 s83, s83, 7
    s_add_u32 s83, s83, s43
    s_mul_i32 s83, s83, 29760
    s_mul_hi_u32 s83, s83, s70
    s_mul_i32 s43, s83, 15421
    s_lshr_b32 s43, s43, 18
    s_sub_i32 s83, s83, 256
    s_ashr_i32 s83, s83, 4
    s_max_i32 s83, s83, s43
    s_sub_u32 s83, s83, s82
    v_add_u32 v104, s82, v247
    v_cmp_le_u32 vcc, s85, v104
    v_mov_b32 v224, s84
    v_mov_b32 v225, s86
    v_cndmask_b32 v224, v224, v225, vcc
    v_add_u32 v104, v104, v224
    v_lshlrev_b32 v104, 15, v104
    v_add_u32 v104, s45, v104
    v_lshlrev_b32 v225, 2, v3
    v_and_b32 v226, 31, v222
    v_and_b32 v227, 15, v222
    v_xor_b32 v227, v227, v3
    v_lshlrev_b32 v227, 4, v227
    v_lshl_add_u32 v192, v226, 8, v227
    v_add_u32 v192, s40, v192
    v_xor_b32 v193, 32, v192
    v_xor_b32 v194, 64, v192
    v_xor_b32 v195, 96, v192
    v_xor_b32 v196, 128, v192
    v_xor_b32 v197, 160, v192
    v_xor_b32 v198, 192, v192
    v_xor_b32 v199, 224, v192
    v_bfe_u32 v226, v222, 2, 2
    v_add_u32 v227, v225, v226
    v_lshlrev_b32 v227, 8, v227
    v_lshl_add_u32 v227, v226, 6, v227
    v_bfe_u32 v226, v222, 4, 1
    v_lshl_add_u32 v227, v226, 5, v227
    v_lshl_add_u32 v227, v6, 3, v227
    v_add_u32 v200, s40, v227
    v_add_u32 v200, 0x2000, v200
    v_xor_b32 v201, 64, v200
    v_xor_b32 v202, 128, v200
    v_xor_b32 v203, 192, v200
    v_bfe_u32 v224, v222, 2, 1
    v_xor_b32 v224, v224, v3
    v_lshl_add_u32 v224, v6, 1, v224
    v_lshlrev_b32 v240, 9, v4
    v_lshl_add_u32 v240, v224, 4, v240
    v_add_u32 v240, s40, v240
    v_lshlrev_b32 v241, 4, v222
    s_lshl_b32 s42, s32, 2
    v_add_u32 v2, s42, v217
    s_add_u32 s42, s42, 148480
    v_add_u32 v241, s42, v241
    s_lshr_b32 s42, s32, 1
    v_xor_b32 v244, s42, v222
    v_lshlrev_b32 v244, 4, v244
    s_and_b32 s43, s32, 1
    s_lshl_b32 s42, s43, 10
    v_add_u32 v244, s42, v244
    v_bfe_u32 v245, v222, 1, 2
    v_lshlrev_b32 v245, 4, v245
    v_add_u32 v245, 148480, v245
    v_lshrrev_b32 v224, 3, v222
    v_mul_u32_u24 v246, 8448, v224
    v_and_b32 v224, 7, v222
    v_lshl_add_u32 v246, v224, 4, v246
    s_mul_i32 s42, s33, 135168
    s_mul_i32 s44, s43, 67584
    s_add_u32 s42, s42, s44
    s_lshl_b32 s44, s34, 7
    s_add_u32 s42, s42, s44
    v_add_u32 v246, s42, v246
    v_mov_b32 v128, 0
    v_mov_b32 v129, 0
    v_mov_b32 v130, 0
    v_mov_b32 v131, 0
    v_mov_b32 v132, 0
    v_mov_b32 v133, 0
    v_mov_b32 v134, 0
    v_mov_b32 v135, 0
    v_mov_b32 v136, 0
    v_mov_b32 v137, 0
    v_mov_b32 v138, 0
    v_mov_b32 v139, 0
    v_mov_b32 v140, 0
    v_mov_b32 v141, 0
    v_mov_b32 v142, 0
    v_mov_b32 v143, 0
    v_mov_b32 v144, 0
    v_mov_b32 v145, 0
    v_mov_b32 v146, 0
    v_mov_b32 v147, 0
    v_mov_b32 v148, 0
    v_mov_b32 v149, 0
    v_mov_b32 v150, 0
    v_mov_b32 v151, 0
    v_mov_b32 v152, 0
    v_mov_b32 v153, 0
    v_mov_b32 v154, 0
    v_mov_b32 v155, 0
    v_mov_b32 v156, 0
    v_mov_b32 v157, 0
    v_mov_b32 v158, 0
    v_mov_b32 v159, 0
    v_mov_b32 v160, 0
    v_mov_b32 v161, 0
    v_mov_b32 v162, 0
    v_mov_b32 v163, 0
    v_mov_b32 v164, 0
    v_mov_b32 v165, 0
    v_mov_b32 v166, 0
    v_mov_b32 v167, 0
    v_mov_b32 v168, 0
    v_mov_b32 v169, 0
    v_mov_b32 v170, 0
    v_mov_b32 v171, 0
    v_mov_b32 v172, 0
    v_mov_b32 v173, 0
    v_mov_b32 v174, 0
    v_mov_b32 v175, 0
    v_mov_b32 v176, 0
    v_mov_b32 v177, 0
    v_mov_b32 v178, 0
    v_mov_b32 v179, 0
    v_mov_b32 v180, 0
    v_mov_b32 v181, 0
    v_mov_b32 v182, 0
    v_mov_b32 v183, 0
    v_mov_b32 v184, 0
    v_mov_b32 v185, 0
    v_mov_b32 v186, 0
    v_mov_b32 v187, 0
    v_mov_b32 v188, 0
    v_mov_b32 v189, 0
    v_mov_b32 v190, 0
    v_mov_b32 v191, 0
    v_mov_b32 v220, 0xf1000000
    v_mov_b32 v221, 0
    v_mov_b32 v239, 0xff800000
    v_mov_b32 v1, 0xff
    s_lshl_b32 s39, s32, 7
    s_waitcnt vmcnt(9)
    ds_write_b64 v7, v[72:73] offset:0
    ds_write_b64 v7, v[74:75] offset:2048
    ds_write_b64 v7, v[76:77] offset:4096
    ds_write_b64 v7, v[78:79] offset:6144
    ds_write_b64 v7, v[80:81] offset:8192
    ds_write_b64 v7, v[82:83] offset:10240
    ds_write_b64 v7, v[84:85] offset:12288
    ds_write_b64 v7, v[86:87] offset:14336
    v_cmp_ne_u64 s[58:59], v[72:73], v[74:75]
    v_cmp_ne_u64 s[60:61], v[72:73], v[76:77]
    v_cmp_ne_u64 s[62:63], v[72:73], v[78:79]
    v_cmp_ne_u64 s[64:65], v[72:73], v[80:81]
    s_or_b64 s[54:55], s[58:59], s[60:61]
    s_or_b64 s[56:57], s[62:63], s[64:65]
    v_cmp_ne_u64 s[58:59], v[72:73], v[82:83]
    v_cmp_ne_u64 s[60:61], v[72:73], v[84:85]
    v_cmp_ne_u64 s[62:63], v[72:73], v[86:87]
    s_or_b64 s[54:55], s[54:55], s[56:57]
    s_or_b64 s[56:57], s[58:59], s[60:61]
    s_or_b64 s[54:55], s[54:55], s[62:63]
    s_or_b64 s[54:55], s[54:55], s[56:57]
    s_ff1_i32_b64 s42, s[54:55]
    s_cselect_b32 s42, s42, 256
    s_lshl_b32 s42, s42, 1
    s_add_u32 s42, s42, s39
    s_add_u32 s42, s42, 1
    v_mov_b32 v228, s42
    ds_write_b32 v2, v228 offset:0
    s_waitcnt vmcnt(8)
    v_mov_b32 v229, 0x2000
    v_cmp_gt_i32 vcc, 1, v215
    v_mov_b32 v216, 0x3e0293ee
    v_min_i32 v215, v215, v229
    v_cndmask_b32 v215, v215, v229, vcc
    v_cndmask_b32 v216, v216, 0, vcc
    v_add_u32 v206, 15, v215
    v_lshrrev_b32 v206, 4, v206
    v_add_u32 v229, 1, v206
    s_mov_b32 s71, 0
    v_lshrrev_b32 v228, 5, v222
    v_max_u32_dpp v229, v229, v229 row_shr:4 row_mask:0xf bank_mask:0xf
    v_lshlrev_b32 v228, 2, v228
    v_sub_u32 v215, v215, v228
    v_max_u32_dpp v229, v229, v229 row_shr:8 row_mask:0xf bank_mask:0xf
    s_nop 1
    v_max_u32_dpp v229, v229, v229 row_bcast:15 row_mask:0xa bank_mask:0xf
L_pw:
    ds_read_b128 v[232:235], v217 offset:0
    s_add_u32 s71, s71, 1
    s_waitcnt lgkmcnt(0)
    v_min3_u32 v232, v232, v233, v234
    v_min3_u32 v232, v232, v235, v229
    s_cmp_gt_u32 s71, 0x100000
    v_readlane_b32 s35, v232, 31
    s_cbranch_scc1 L_end
    s_sub_u32 s35, s35, 1
    s_cbranch_scc1 L_pw
    v_subrev_u32 v206, s35, v206
    v_max_i32 v206, 0, v206
    s_mul_i32 s47, s35, 17
    v_mov_b32 v205, v206
    s_nop 1
    v_add_u32_dpp v205, v205, v205 row_shr:4 row_mask:0xf bank_mask:0xf bound_ctrl:0
    s_nop 1
    v_add_u32_dpp v205, v205, v205 row_shr:8 row_mask:0xf bank_mask:0xf bound_ctrl:0
    s_nop 1
    v_add_u32_dpp v205, v205, v205 row_bcast:15 row_mask:0xa bank_mask:0xf
    s_nop 0
    v_readlane_b32 s48, v205, 31
    v_add_u32 v205, s35, v205
    v_sub_u32 v204, v205, v206
    s_lshl_b32 s46, s48, 4
    s_add_u32 s46, s46, s47
    v_and_b32 v232, 1, v230
    v_mul_i32_i24 v232, s73, v232
    v_lshl_add_u32 v231, v230, 7, v232
    v_mul_u32_u24 v231, s46, v231
    v_mul_hi_u32 v231, s70, v231
    v_mul_u32_u24 v232, 15421, v231
    v_subrev_u32 v231, s47, v231
    v_lshrrev_b32 v232, 18, v232
    v_ashrrev_i32 v231, 4, v231
    v_add_u32 v231, s35, v231
    v_max_i32 v231, v231, v232
    v_lshlrev_b32 v233, 7, v4
    v_readlane_b32 s36, v231, 0
    v_readlane_b32 s37, v231, 1
    v_sub_u32 v233, v233, v204
    v_add_u32 v233, s35, v233
    v_add_u32 v234, s36, v247
    v_cmp_lt_u32 s[60:61], s36, v205
    v_mov_b32 v235, 0
    s_sub_u32 s38, s37, s36
    s_ff1_i32_b32 s42, s60
    s_max_i32 s42, s42, 0
L_bsel:
    v_readlane_b32 s43, v204, s42
    v_readlane_b32 s44, v233, s42
    v_readlane_b32 s51, v205, s42
    s_add_u32 s42, s42, 4
    v_cmp_le_u32 vcc, s43, v234
    v_mov_b32 v236, s44
    s_cmp_lt_u32 s51, s37
    v_cndmask_b32 v235, v235, v236, vcc
    s_cbranch_scc1 L_bsel
    v_add_u32 v235, v235, v234
    v_cmp_gt_u32 s[68:69], s38, v247
    v_and_b32 v235, 0xfff, v235
    v_lshlrev_b32 v236, 2, v235
    v_add_u32 v236, 131072, v236
    ds_read_b32 v212, v236
    v_and_b32 v213, 511, v235
    v_lshlrev_b32 v213, 4, v213
    v_lshrrev_b32 v214, 9, v235
    v_lshlrev_b32 v214, 2, v214
    v_lshlrev_b32 v214, v214, 15
    v_cmp_gt_u32 s[58:59], s35, v234
    v_cmp_gt_u32 s[62:63], s37, v204
    v_cmp_lt_u32 s[64:65], 0, v206
    v_cndmask_b32 v214, v214, -1, s[58:59]
    v_cndmask_b32 v214, 0, v214, s[68:69]
    s_and_b64 s[66:67], s[60:61], s[62:63]
    s_and_b64 s[66:67], s[66:67], s[64:65]
    s_cmp_lt_u32 s36, s35
    s_cselect_b32 s42, s37, 0
    s_cmp_gt_u32 s42, 0
    s_cselect_b64 s[66:67], -1, s[66:67]
    v_mov_b32 v237, 0x7fff0000
    v_lshlrev_b32 v236, 2, v247
    v_add_u32 v236, 147456, v236
    v_mov_b32 v238, s38
    s_bcnt1_i32_b64 s41, s[68:69]
    s_add_u32 s41, s41, 1
    s_lshr_b32 s41, s41, 1
    s_add_u32 s79, s38, 1
    s_lshr_b32 s79, s79, 1
    s_waitcnt lgkmcnt(0)
    v_lshlrev_b32 v212, 15, v212
    v_add_u32 v212, s45, v212
    v_cmp_ne_u32 vcc, v212, v104
    v_cndmask_b32 v212, v237, v212, s[68:69]
    ds_write_b32 v236, v212
    ds_write_b32 v217, v238 offset:80
    s_and_b64 vcc, vcc, s[68:69]
    s_xor_b32 s42, s38, s83
    s_or_b32 s42, s42, vcc_lo
    s_or_b32 s42, s42, vcc_hi
    s_cselect_b32 s42, 0x101, 1
    v_mov_b32 v224, s42
    s_mov_b64 exec, 1
    ds_add_u32 v217, v224 offset:68
    s_mov_b64 exec, -1
    s_andn2_b32 s42, s66, s80
    s_cbranch_scc0 L_qok
    s_waitcnt vmcnt(0)
    global_load_dwordx4 v[8:11], v5, s[4:5] offset:0
    global_load_dwordx4 v[12:15], v5, s[4:5] offset:32
    global_load_dwordx4 v[16:19], v5, s[4:5] offset:64
    global_load_dwordx4 v[20:23], v5, s[4:5] offset:96
    global_load_dwordx4 v[24:27], v5, s[4:5] offset:128
    global_load_dwordx4 v[28:31], v5, s[4:5] offset:160
    global_load_dwordx4 v[32:35], v5, s[4:5] offset:192
    global_load_dwordx4 v[36:39], v5, s[4:5] offset:224
L_qok:
    s_mov_b32 s71, 0
L_ver:
    ds_read_b32 v224, v217 offset:68
    s_add_u32 s71, s71, 1
    s_waitcnt lgkmcnt(0)
    v_readfirstlane_b32 s42, v224
    s_cmp_gt_u32 s71, 0x100000
    s_cbranch_scc1 L_end
    s_cmp_eq_u32 s42, 4
    s_cselect_b32 s43, 0, 4
    s_cbranch_scc1 L_verd
    s_cmp_lt_u32 s42, 0x10000
    s_cbranch_scc1 L_ver
L_verd:
    s_add_u32 s43, s43, 72
    v_add_u32 v218, s43, v217
    s_mov_b32 s39, 0
    s_mov_b32 s77, 0
    s_mov_b32 s75, s32
    s_mov_b32 s78, s32
    s_mov_b32 s88, 8
    s_mov_b32 s87, 0
    v_mov_b32 v233, 1
    v_mov_b32 v235, 1
    s_waitcnt vmcnt(0)
    s_cmp_eq_u32 s41, 0
    s_cbranch_scc1 L_zero
L_qk:
    s_add_u32 s43, s39, 1
    v_readlane_b32 s51, v213, s39
    v_readlane_b32 s52, v213, s43
    v_readlane_b32 s54, v214, s39
    v_readlane_b32 s56, v214, s43
    s_add_u32 s39, s39, 2
    v_subrev_u32 v224, s51, v215
    v_subrev_u32 v225, s52, v215
    s_mov_b32 s55, s54
    s_mov_b32 s57, s56
    s_cmp_gt_u32 s77, s75
    s_cbranch_scc1 L_wk_ok
    s_mov_b32 s71, 0
L_wk:
    ds_read_b32 v232, v218
    s_add_u32 s71, s71, 1
    s_waitcnt lgkmcnt(0)
    v_readfirstlane_b32 s77, v232
    s_cmp_gt_u32 s77, s75
    s_cbranch_scc1 L_wk_ok
    s_cmp_gt_u32 s71, 0x100000
    s_cbranch_scc0 L_wk
    s_endpgm
L_wk_ok:
    ds_read_b128 v[40:43], v192
    ds_read_b128 v[44:47], v193
    ds_read_b128 v[48:51], v194
    ds_read_b128 v[52:55], v195
    ds_read_b128 v[56:59], v196
    ds_read_b128 v[60:63], v197
    ds_read_b128 v[64:67], v198
    ds_read_b128 v[68:71], v199
    ds_write_b32 v2, v233 offset:48
    v_cmp_gt_i32 s[58:59], 16, v224
    v_cmp_gt_i32 s[60:61], 16, v225
    v_add_u32 v233, 1, v233
    s_waitcnt lgkmcnt(8)
    v_mfma_f32_32x32x16_bf16 v[104:119], v[40:43], v[8:11], 0
    s_waitcnt lgkmcnt(7)
    v_mfma_f32_32x32x16_bf16 v[104:119], v[44:47], v[12:15], v[104:119]
    s_waitcnt lgkmcnt(6)
    v_mfma_f32_32x32x16_bf16 v[104:119], v[48:51], v[16:19], v[104:119]
    s_waitcnt lgkmcnt(5)
    v_mfma_f32_32x32x16_bf16 v[104:119], v[52:55], v[20:23], v[104:119]
    s_waitcnt lgkmcnt(4)
    v_mfma_f32_32x32x16_bf16 v[104:119], v[56:59], v[24:27], v[104:119]
    s_waitcnt lgkmcnt(3)
    v_mfma_f32_32x32x16_bf16 v[104:119], v[60:63], v[28:31], v[104:119]
    s_waitcnt lgkmcnt(2)
    v_mfma_f32_32x32x16_bf16 v[104:119], v[64:67], v[32:35], v[104:119]
    s_waitcnt lgkmcnt(1)
    v_mfma_f32_32x32x16_bf16 v[104:119], v[68:71], v[36:39], v[104:119]
    s_and_b64 s[58:59], s[58:59], s[54:55]
    s_and_b64 s[60:61], s[60:61], s[56:57]
    v_xor_b32 v192, 0x4000, v192
    v_xor_b32 v193, 0x4000, v193
    v_xor_b32 v194, 0x4000, v194
    v_xor_b32 v195, 0x4000, v195
    v_xor_b32 v196, 0x4000, v196
    v_xor_b32 v197, 0x4000, v197
    v_xor_b32 v198, 0x4000, v198
    v_xor_b32 v199, 0x4000, v199
    s_or_b64 s[58:59], s[58:59], s[60:61]
    s_cbranch_scc0 L_fast
    v_cmp_lt_i32 s[58:59], 0, v224
    v_cmp_lt_i32 s[60:61], 1, v224
    v_cmp_lt_i32 s[62:63], 2, v224
    v_cmp_lt_i32 s[64:65], 3, v224
    s_nop 0
    v_cndmask_b32 v104, v239, v104, s[58:59]
    v_cndmask_b32 v105, v239, v105, s[60:61]
    v_cndmask_b32 v106, v239, v106, s[62:63]
    v_cndmask_b32 v107, v239, v107, s[64:65]
    v_cmp_lt_i32 s[58:59], 8, v224
    v_cmp_lt_i32 s[60:61], 9, v224
    v_cmp_lt_i32 s[62:63], 10, v224
    v_cmp_lt_i32 s[64:65], 11, v224
    s_nop 0
    v_cndmask_b32 v108, v239, v108, s[58:59]
    v_cndmask_b32 v109, v239, v109, s[60:61]
    v_cndmask_b32 v110, v239, v110, s[62:63]
    v_cndmask_b32 v111, v239, v111, s[64:65]
    v_cmp_lt_i32 s[58:59], 0, v225
    v_cmp_lt_i32 s[60:61], 1, v225
    v_cmp_lt_i32 s[62:63], 2, v225
    v_cmp_lt_i32 s[64:65], 3, v225
    s_nop 0
    v_cndmask_b32 v112, v239, v112, s[58:59]
    v_cndmask_b32 v113, v239, v113, s[60:61]
    v_cndmask_b32 v114, v239, v114, s[62:63]
    v_cndmask_b32 v115, v239, v115, s[64:65]
    v_cmp_lt_i32 s[58:59], 8, v225
    v_cmp_lt_i32 s[60:61], 9, v225
    v_cmp_lt_i32 s[62:63], 10, v225
    v_cmp_lt_i32 s[64:65], 11, v225
    s_nop 0
    v_cndmask_b32 v116, v239, v116, s[58:59]
    v_cndmask_b32 v117, v239, v117, s[60:61]
    v_cndmask_b32 v118, v239, v118, s[62:63]
    v_cndmask_b32 v119, v239, v119, s[64:65]
L_fast:
    v_max3_f32 v226, v104, v105, v106
    v_max3_f32 v226, v226, v107, v108
    v_max3_f32 v226, v226, v109, v110
    v_max_f32 v226, v226, v111
    v_mul_f32 v226, v226, v216
    v_max3_f32 v227, v112, v113, v114
    v_max3_f32 v227, v227, v115, v116
    v_max3_f32 v227, v227, v117, v118
    v_max_f32 v227, v227, v119
    v_mul_f32 v227, v227, v216
    v_cndmask_b32 v226, v239, v226, s[54:55]
    v_cndmask_b32 v227, v239, v227, s[56:57]
    v_max3_f32 v226, v226, v227, v220
    v_mov_b32 v227, v226
    s_nop 1
    v_permlane32_swap_b32 v226, v227
    s_nop 1
    v_max_f32 v226, v226, v227
    v_ashrrev_i32 v227, 31, v226
    v_bfi_b32 v227, v227, 0, v1
    v_add_u32 v226, v226, v227
    v_and_b32 v226, 0xffffff00, v226
    v_sub_f32 v228, v220, v226
    v_cmp_neq_f32 vcc, v220, v226
    v_exp_f32 v228, v228
    v_mov_b32 v220, v226
    v_cndmask_b32 v229, v239, -v226, s[54:55]
    v_cndmask_b32 v230, v239, -v226, s[56:57]
    v_fma_f32 v104, v104, v216, v229
    v_fma_f32 v105, v105, v216, v229
    v_fma_f32 v106, v106, v216, v229
    v_fma_f32 v107, v107, v216, v229
    v_fma_f32 v108, v108, v216, v229
    v_fma_f32 v109, v109, v216, v229
    v_fma_f32 v110, v110, v216, v229
    v_fma_f32 v111, v111, v216, v229
    v_fma_f32 v112, v112, v216, v230
    v_fma_f32 v113, v113, v216, v230
    v_fma_f32 v114, v114, v216, v230
    v_fma_f32 v115, v115, v216, v230
    v_fma_f32 v116, v116, v216, v230
    v_fma_f32 v117, v117, v216, v230
    v_fma_f32 v118, v118, v216, v230
    v_fma_f32 v119, v119, v216, v230
    v_exp_f32 v104, v104
    v_exp_f32 v105, v105
    v_exp_f32 v106, v106
    v_exp_f32 v107, v107
    v_exp_f32 v108, v108
    v_exp_f32 v109, v109
    v_exp_f32 v110, v110
    v_exp_f32 v111, v111
    v_exp_f32 v112, v112
    v_exp_f32 v113, v113
    v_exp_f32 v114, v114
    v_exp_f32 v115, v115
    v_exp_f32 v116, v116
    v_exp_f32 v117, v117
    v_exp_f32 v118, v118
    v_exp_f32 v119, v119
    v_mul_f32 v221, v221, v228
    v_cvt_pk_bf16_f32 v120, v104, v105
    v_cvt_pk_bf16_f32 v121, v106, v107
    v_cvt_pk_bf16_f32 v122, v108, v109
    v_cvt_pk_bf16_f32 v123, v110, v111
    v_cvt_pk_bf16_f32 v124, v112, v113
    v_cvt_pk_bf16_f32 v125, v114, v115
    v_cvt_pk_bf16_f32 v126, v116, v117
    v_cvt_pk_bf16_f32 v127, v118, v119
    v_add_f32 v104, v104, v105
    v_add_f32 v106, v106, v107
    v_add_f32 v108, v108, v109
    v_add_f32 v110, v110, v111
    v_add_f32 v112, v112, v113
    v_add_f32 v114, v114, v115
    v_add_f32 v116, v116, v117
    v_add_f32 v118, v118, v119
    v_add_f32 v104, v104, v106
    v_add_f32 v108, v108, v110
    v_add_f32 v112, v112, v114
    v_add_f32 v116, v116, v118
    v_add_f32 v104, v104, v108
    v_add_f32 v112, v112, v116
    v_add_f32 v221, v221, v104
    v_add_f32 v221, v221, v112
    s_min_u32 s76, s88, s79
    s_add_u32 s76, s76, s78
    s_cmp_eq_u32 s87, 0
    s_cbranch_scc1 L_first
    s_mov_b64 s[90:91], vcc
    s_cmp_gt_u32 s77, s76
    s_cbranch_scc1 L_wv_ok
    s_mov_b32 s71, 0
L_wv:
    ds_read_b32 v232, v218
    s_add_u32 s71, s71, 1
    s_waitcnt lgkmcnt(0)
    v_readfirstlane_b32 s77, v232
    s_cmp_gt_u32 s77, s76
    s_cbranch_scc1 L_wv_ok
    s_cmp_gt_u32 s71, 0x100000
    s_cbranch_scc0 L_wv
    s_endpgm
L_wv_ok:
    ds_read_b64_tr_b16 v[72:73], v200 offset:0
    ds_read_b64_tr_b16 v[74:75], v200 offset:2048
    ds_read_b64_tr_b16 v[76:77], v200 offset:4096
    ds_read_b64_tr_b16 v[78:79], v200 offset:6144
    ds_read_b64_tr_b16 v[80:81], v201 offset:0
    ds_read_b64_tr_b16 v[82:83], v201 offset:2048
    ds_read_b64_tr_b16 v[84:85], v201 offset:4096
    ds_read_b64_tr_b16 v[86:87], v201 offset:6144
    ds_read_b64_tr_b16 v[88:89], v202 offset:0
    ds_read_b64_tr_b16 v[90:91], v202 offset:2048
    ds_read_b64_tr_b16 v[92:93], v202 offset:4096
    ds_read_b64_tr_b16 v[94:95], v202 offset:6144
    ds_read_b64_tr_b16 v[96:97], v203 offset:0
    ds_read_b64_tr_b16 v[98:99], v203 offset:2048
    s_waitcnt lgkmcnt(12)
    v_mfma_f32_32x32x16_bf16 v[128:143], v[72:75], v[204:207], v[128:143]
    ds_read_b64_tr_b16 v[100:101], v203 offset:4096
    ds_read_b64_tr_b16 v[102:103], v203 offset:6144
    ds_write_b32 v2, v235 offset:112
    s_waitcnt lgkmcnt(13)
    v_mfma_f32_32x32x16_bf16 v[128:143], v[76:79], v[208:211], v[128:143]
    s_waitcnt lgkmcnt(11)
    v_mfma_f32_32x32x16_bf16 v[144:159], v[80:83], v[204:207], v[144:159]
    s_waitcnt lgkmcnt(9)
    v_mfma_f32_32x32x16_bf16 v[144:159], v[84:87], v[208:211], v[144:159]
    s_waitcnt lgkmcnt(7)
    v_mfma_f32_32x32x16_bf16 v[160:175], v[88:91], v[204:207], v[160:175]
    s_waitcnt lgkmcnt(5)
    v_mfma_f32_32x32x16_bf16 v[160:175], v[92:95], v[208:211], v[160:175]
    s_waitcnt lgkmcnt(3)
    v_mfma_f32_32x32x16_bf16 v[176:191], v[96:99], v[204:207], v[176:191]
    s_waitcnt lgkmcnt(1)
    v_mfma_f32_32x32x16_bf16 v[176:191], v[100:103], v[208:211], v[176:191]
    v_xor_b32 v200, 0x4000, v200
    v_xor_b32 v201, 0x4000, v201
    v_xor_b32 v202, 0x4000, v202
    v_xor_b32 v203, 0x4000, v203
    v_add_u32 v235, 1, v235
    s_add_u32 s78, s78, 4
    s_add_u32 s88, s88, 4
    s_min_u32 s76, s88, s79
    s_add_u32 s76, s76, s78
    s_add_u32 s75, s75, 4
    s_cmp_eq_u64 s[90:91], 0
    s_cbranch_scc1 L_first
    v_pk_mul_f32 v[128:129], v[128:129], v[228:229] op_sel_hi:[1,0]
    v_pk_mul_f32 v[130:131], v[130:131], v[228:229] op_sel_hi:[1,0]
    v_pk_mul_f32 v[132:133], v[132:133], v[228:229] op_sel_hi:[1,0]
    v_pk_mul_f32 v[134:135], v[134:135], v[228:229] op_sel_hi:[1,0]
    v_pk_mul_f32 v[136:137], v[136:137], v[228:229] op_sel_hi:[1,0]
    v_pk_mul_f32 v[138:139], v[138:139], v[228:229] op_sel_hi:[1,0]
    v_pk_mul_f32 v[140:141], v[140:141], v[228:229] op_sel_hi:[1,0]
    v_pk_mul_f32 v[142:143], v[142:143], v[228:229] op_sel_hi:[1,0]
    v_pk_mul_f32 v[144:145], v[144:145], v[228:229] op_sel_hi:[1,0]
    v_pk_mul_f32 v[146:147], v[146:147], v[228:229] op_sel_hi:[1,0]
    v_pk_mul_f32 v[148:149], v[148:149], v[228:229] op_sel_hi:[1,0]
    v_pk_mul_f32 v[150:151], v[150:151], v[228:229] op_sel_hi:[1,0]
    v_pk_mul_f32 v[152:153], v[152:153], v[228:229] op_sel_hi:[1,0]
    v_pk_mul_f32 v[154:155], v[154:155], v[228:229] op_sel_hi:[1,0]
    v_pk_mul_f32 v[156:157], v[156:157], v[228:229] op_sel_hi:[1,0]
    v_pk_mul_f32 v[158:159], v[158:159], v[228:229] op_sel_hi:[1,0]
    v_pk_mul_f32 v[160:161], v[160:161], v[228:229] op_sel_hi:[1,0]
    v_pk_mul_f32 v[162:163], v[162:163], v[228:229] op_sel_hi:[1,0]
    v_pk_mul_f32 v[164:165], v[164:165], v[228:229] op_sel_hi:[1,0]
    v_pk_mul_f32 v[166:167], v[166:167], v[228:229] op_sel_hi:[1,0]
    v_pk_mul_f32 v[168:169], v[168:169], v[228:229] op_sel_hi:[1,0]
    v_pk_mul_f32 v[170:171], v[170:171], v[228:229] op_sel_hi:[1,0]
    v_pk_mul_f32 v[172:173], v[172:173], v[228:229] op_sel_hi:[1,0]
    v_pk_mul_f32 v[174:175], v[174:175], v[228:229] op_sel_hi:[1,0]
    v_pk_mul_f32 v[176:177], v[176:177], v[228:229] op_sel_hi:[1,0]
    v_pk_mul_f32 v[178:179], v[178:179], v[228:229] op_sel_hi:[1,0]
    v_pk_mul_f32 v[180:181], v[180:181], v[228:229] op_sel_hi:[1,0]
    v_pk_mul_f32 v[182:183], v[182:183], v[228:229] op_sel_hi:[1,0]
    v_pk_mul_f32 v[184:185], v[184:185], v[228:229] op_sel_hi:[1,0]
    v_pk_mul_f32 v[186:187], v[186:187], v[228:229] op_sel_hi:[1,0]
    v_pk_mul_f32 v[188:189], v[188:189], v[228:229] op_sel_hi:[1,0]
    v_pk_mul_f32 v[190:191], v[190:191], v[228:229] op_sel_hi:[1,0]
L_first:
    s_sub_u32 s41, s41, 1
    s_cmp_eq_u32 s41, 0
    s_cbranch_scc1 L_last
    v_mov_b32 v204, v120
    v_mov_b32 v205, v121
    v_mov_b32 v206, v122
    v_mov_b32 v207, v123
    v_mov_b32 v208, v124
    v_mov_b32 v209, v125
    v_mov_b32 v210, v126
    v_mov_b32 v211, v127
    s_mov_b32 s87, 1
    s_add_u32 s75, s75, 4
    s_branch L_qk
L_zero:
    v_mov_b32 v224, v221
    s_mov_b32 s58, 0
    s_mov_b32 s59, -1
    v_permlane32_swap_b32 v221, v224
    v_mov_b32 v234, 1
    s_lshr_b32 s42, s32, 1
    v_add_f32 v224, v221, v224
    v_cndmask_b32 v224, v220, v224, s[58:59]
    ds_write_b32 v241, v224
    ds_read_b32 v223, v217 offset:32
    s_lshl_b32 s42, s42, 2
    s_lshl_b32 s43, 0x01010101, s42
    s_and_b32 s39, s66, s43
    s_mov_b32 s58, 0xaaaaaaaa
    s_mov_b32 s59, 0xaaaaaaaa
    s_movk_i32 s44, 0xf000
    s_waitcnt lgkmcnt(0)
    ds_write_b32 v2, v234 offset:16
    ds_write_b128 v240, v[128:131] offset:0
    ds_write_b128 v240, v[132:135] offset:128
    ds_write_b128 v240, v[136:139] offset:256
    ds_write_b128 v240, v[140:143] offset:384
    ds_write_b128 v240, v[144:147] offset:512
    ds_write_b128 v240, v[148:151] offset:640
    ds_write_b128 v240, v[152:155] offset:768
    ds_write_b128 v240, v[156:159] offset:896
    ds_write_b128 v240, v[160:163] offset:1024
    ds_write_b128 v240, v[164:167] offset:1152
    ds_write_b128 v240, v[168:171] offset:1280
    ds_write_b128 v240, v[172:175] offset:1408
    ds_write_b128 v240, v[176:179] offset:1536
    ds_write_b128 v240, v[180:183] offset:1664
    ds_write_b128 v240, v[184:187] offset:1792
    ds_write_b128 v240, v[188:191] offset:1920
    s_branch L_cnt
L_last:
    v_mov_b32 v224, v221
    s_mov_b32 s58, 0
    s_mov_b32 s59, -1
    v_permlane32_swap_b32 v221, v224
    v_mov_b32 v234, 1
    s_lshr_b32 s42, s32, 1
    v_add_f32 v224, v221, v224
    v_cndmask_b32 v224, v220, v224, s[58:59]
    ds_write_b32 v241, v224
    ds_read_b32 v223, v217 offset:32
    s_lshl_b32 s42, s42, 2
    s_lshl_b32 s43, 0x01010101, s42
    s_and_b32 s39, s66, s43
    s_mov_b32 s58, 0xaaaaaaaa
    s_mov_b32 s59, 0xaaaaaaaa
    s_movk_i32 s44, 0xf000
    s_waitcnt lgkmcnt(0)
    s_cmp_gt_u32 s77, s76
    s_cbranch_scc1 L_wz_ok
    s_mov_b32 s71, 0
L_wz:
    ds_read_b32 v232, v218
    s_add_u32 s71, s71, 1
    s_waitcnt lgkmcnt(0)
    v_readfirstlane_b32 s77, v232
    s_cmp_gt_u32 s77, s76
    s_cbranch_scc1 L_wz_ok
    s_cmp_gt_u32 s71, 0x100000
    s_cbranch_scc0 L_wz
    s_endpgm
L_wz_ok:
    ds_read_b64_tr_b16 v[72:73], v200 offset:0
    ds_read_b64_tr_b16 v[74:75], v200 offset:2048
    ds_read_b64_tr_b16 v[76:77], v200 offset:4096
    ds_read_b64_tr_b16 v[78:79], v200 offset:6144
    ds_read_b64_tr_b16 v[80:81], v201 offset:0
    ds_read_b64_tr_b16 v[82:83], v201 offset:2048
    ds_read_b64_tr_b16 v[84:85], v201 offset:4096
    ds_read_b64_tr_b16 v[86:87], v201 offset:6144
    ds_read_b64_tr_b16 v[88:89], v202 offset:0
    ds_read_b64_tr_b16 v[90:91], v202 offset:2048
    ds_read_b64_tr_b16 v[92:93], v202 offset:4096
    ds_read_b64_tr_b16 v[94:95], v202 offset:6144
    ds_read_b64_tr_b16 v[96:97], v203 offset:0
    ds_read_b64_tr_b16 v[98:99], v203 offset:2048
    s_waitcnt lgkmcnt(12)
    v_mfma_f32_32x32x16_bf16 v[128:143], v[72:75], v[120:123], v[128:143]
    ds_read_b64_tr_b16 v[100:101], v203 offset:4096
    ds_read_b64_tr_b16 v[102:103], v203 offset:6144
    s_waitcnt lgkmcnt(12)
    v_mfma_f32_32x32x16_bf16 v[128:143], v[76:79], v[124:127], v[128:143]
    s_waitcnt lgkmcnt(10)
    v_mfma_f32_32x32x16_bf16 v[144:159], v[80:83], v[120:123], v[144:159]
    s_waitcnt lgkmcnt(8)
    v_mfma_f32_32x32x16_bf16 v[144:159], v[84:87], v[124:127], v[144:159]
    s_waitcnt lgkmcnt(6)
    v_mfma_f32_32x32x16_bf16 v[160:175], v[88:91], v[120:123], v[160:175]
    s_waitcnt lgkmcnt(0)
    v_mfma_f32_32x32x16_bf16 v[160:175], v[92:95], v[124:127], v[160:175]
    ds_write_b32 v2, v234 offset:16
    s_nop 1
    s_nop 0
    ds_write_b128 v240, v[128:131] offset:0
    ds_write_b128 v240, v[132:135] offset:128
    ds_write_b128 v240, v[136:139] offset:256
    ds_write_b128 v240, v[140:143] offset:384
    v_mfma_f32_32x32x16_bf16 v[176:191], v[96:99], v[120:123], v[176:191]
    v_mfma_f32_32x32x16_bf16 v[176:191], v[100:103], v[124:127], v[176:191]
    ds_write_b128 v240, v[144:147] offset:512
    ds_write_b128 v240, v[148:151] offset:640
    ds_write_b128 v240, v[152:155] offset:768
    ds_write_b128 v240, v[156:159] offset:896
    ds_write_b128 v240, v[160:163] offset:1024
    ds_write_b128 v240, v[164:167] offset:1152
    ds_write_b128 v240, v[168:171] offset:1280
    ds_write_b128 v240, v[172:175] offset:1408
    s_nop 3
    ds_write_b128 v240, v[176:179] offset:1536
    ds_write_b128 v240, v[180:183] offset:1664
    ds_write_b128 v240, v[184:187] offset:1792
    ds_write_b128 v240, v[188:191] offset:1920
L_cnt:
    s_mov_b64 exec, 1
    ds_add_u32 v217, v234 offset:64
    s_mov_b64 exec, -1
    s_mov_b32 s71, 0
    s_cmp_eq_u32 s39, 0
    s_cbranch_scc1 L_sdone
L_wc:
    ds_read_b32 v233, v217 offset:64
    s_add_u32 s71, s71, 1
    v_readfirstlane_b32 s53, v223
    s_waitcnt lgkmcnt(0)
    v_readfirstlane_b32 s42, v233
    s_cmp_gt_u32 s71, 0x100000
    s_cbranch_scc1 L_end
    s_cmp_lt_u32 s42, 4
    s_cbranch_scc1 L_wc
    s_cmp_lg_u32 s53, 0
    s_cbranch_scc1 L_item
    ds_read_b32 v223, v217 offset:32
    s_waitcnt lgkmcnt(0)
    s_branch L_wc
L_item:
    s_ff1_i32_b32 s42, s39
    s_bitset0_b32 s39, s42
    s_lshl_b32 s43, s42, 4
    v_add_u32 v224, s43, v245
    s_lshl_b32 s43, s42, 9
    v_add_u32 v225, s43, v244
    ds_read_b128 v[104:107], v224
    ds_read_b128 v[108:111], v224 offset:512
    v_add_u32 v228, 0x10000, v225
    ds_read_b128 v[40:43], v225 offset:0
    ds_read_b128 v[44:47], v225 offset:32768
    ds_read_b128 v[48:51], v228 offset:0
    ds_read_b128 v[52:55], v228 offset:32768
    s_mul_i32 s45, s42, 271360
    v_lshrrev_b32 v233, 12, v223
    s_waitcnt lgkmcnt(5)
    v_max3_f32 v226, v104, v105, v106
    v_max_f32 v226, v226, v107
    v_sub_f32 v104, v104, v226
    v_sub_f32 v105, v105, v226
    v_sub_f32 v106, v106, v226
    v_sub_f32 v107, v107, v226
    v_exp_f32 v104, v104
    v_exp_f32 v105, v105
    v_exp_f32 v106, v106
    v_exp_f32 v107, v107
    s_waitcnt lgkmcnt(3)
    v_mul_f32 v227, v104, v108
    v_mul_f32 v112, v104, v40
    v_mul_f32 v113, v104, v41
    v_mul_f32 v114, v104, v42
    v_mul_f32 v115, v104, v43
    v_fmac_f32 v227, v105, v109
    v_fmac_f32 v227, v106, v110
    v_fmac_f32 v227, v107, v111
    v_add_u32 v227, 0x80, v227
    v_cndmask_b32 v227, v226, v227, s[58:59]
    v_lshrrev_b32 v234, 8, v227
    v_lshrrev_b32 v235, 20, v227
    s_waitcnt lgkmcnt(0)
    v_fmac_f32 v112, v105, v44
    v_fmac_f32 v113, v105, v45
    v_fmac_f32 v114, v105, v46
    v_fmac_f32 v115, v105, v47
    v_fmac_f32 v112, v106, v48
    v_fmac_f32 v113, v106, v49
    v_fmac_f32 v114, v106, v50
    v_fmac_f32 v115, v106, v51
    v_fmac_f32 v112, v107, v52
    v_fmac_f32 v113, v107, v53
    v_fmac_f32 v114, v107, v54
    v_fmac_f32 v115, v107, v55
    v_bfi_b32 v112, s44, v112, v223
    v_bfi_b32 v113, s44, v113, v233
    v_bfi_b32 v114, s44, v114, v234
    v_bfi_b32 v115, s44, v115, v235
    buffer_store_dwordx4 v[112:115], v246, s[28:31], s45 offen sc1
    s_cmp_lg_u32 s39, 0
    s_cbranch_scc1 L_item
L_sdone:
    s_endpgm
L_helper:
    s_setprio 2
    s_mov_b32 s28, s18
    s_mov_b32 s29, s19
    s_mov_b32 s30, 11534336
    s_mov_b32 s31, 0x20000
    s_lshl_b32 s42, s32, 2
    v_add_u32 v6, s42, v217
    s_lshr_b32 s51, s2, 5
    s_and_b32 s52, s2, 7
    s_bfe_u32 s39, s2, 0x20003
    s_lshl_b32 s39, s39, 2
    s_add_u32 s39, s39, s32
    v_and_b32 v15, 7, v222
    v_lshlrev_b32 v8, 4, v15
    s_mul_i32 s42, s52, 135168
    s_mul_i32 s43, s51, 1085440
    s_add_u32 s42, s42, s43
    s_mul_i32 s43, s39, 8448
    s_add_u32 s42, s42, s43
    v_add_u32 v8, s42, v8
    v_lshrrev_b32 v16, 1, v15
    v_lshlrev_b32 v16, 8, v16
    s_lshl_b32 s42, s51, 13
    s_lshl_b32 s43, s52, 10
    s_add_u32 s42, s42, s43
    s_lshl_b32 s43, s39, 4
    s_add_u32 s42, s42, s43
    v_and_b32 v96, 1, v15
    v_lshl_add_u32 v16, v96, 3, v16
    v_lshrrev_b32 v96, 4, v222
    v_lshl_add_u32 v16, v96, 1, v16
    v_add_u32 v16, s42, v16
    v_lshrrev_b32 v10, 3, v222
    v_mov_b32 v13, 0xf1000000
    v_mov_b32 v90, v13
    v_mov_b32 v91, 0
    v_mov_b32 v92, 0
    v_mov_b32 v93, 0
    v_mov_b32 v94, 0
    v_mov_b32 v95, 0
    s_mov_b32 s49, 0
    s_movk_i32 s50, 0xfff
    s_cmp_lg_u32 s32, 1
    s_cbranch_scc1 L_ltag
    v_and_b32 v4, 0x1c, v222
    v_mov_b32 v7, 0
    global_load_dword v215, v4, s[12:13]
    s_add_u32 s44, s18, 10485760
    s_addc_u32 s45, s19, 0
    s_load_dword s82, s[44:45], 0
    s_mov_b32 s70, 1156116
    s_movk_i32 s73, 3
    s_movk_i32 s74, 29
    s_cmp_ge_u32 s52, 1
    s_cselect_b32 s70, 838861, s70
    s_cmovk_i32 s73, -3
    s_cmovk_i32 s74, 40
    s_cmp_ge_u32 s52, 2
    s_cselect_b32 s70, 1157986, s70
    s_cmovk_i32 s74, 29
    s_cmp_ge_u32 s52, 3
    s_cselect_b32 s70, 1156116, s70
    s_cmovk_i32 s73, 3
    s_cmp_ge_u32 s52, 4
    s_cselect_b32 s70, 1157986, s70
    s_cmovk_i32 s73, -3
    s_cmp_ge_u32 s52, 5
    s_cselect_b32 s70, 838861, s70
    s_cmovk_i32 s73, 3
    s_cmovk_i32 s74, 40
    s_cmp_ge_u32 s52, 6
    s_cselect_b32 s70, 1156116, s70
    s_cmovk_i32 s74, 29
    s_cmp_ge_u32 s52, 7
    s_cselect_b32 s70, 1083220, s70
    s_cmovk_i32 s73, -3
    s_cmovk_i32 s74, 31
    s_waitcnt vmcnt(0) lgkmcnt(0)
    v_mov_b32 v229, 0x2000
    v_cmp_gt_i32 vcc, 1, v215
    v_mov_b32 v216, 0x3e0293ee
    v_min_i32 v215, v215, v229
    v_cndmask_b32 v215, v215, v229, vcc
    v_cndmask_b32 v216, v216, 0, vcc
    v_add_u32 v206, 15, v215
    v_lshrrev_b32 v206, 4, v206
    v_add_u32 v229, 1, v206
    s_mov_b32 s71, 0
    v_lshrrev_b32 v228, 5, v222
    v_max_u32_dpp v229, v229, v229 row_shr:4 row_mask:0xf bank_mask:0xf
    v_lshlrev_b32 v228, 2, v228
    v_sub_u32 v215, v215, v228
    v_max_u32_dpp v229, v229, v229 row_shr:8 row_mask:0xf bank_mask:0xf
    s_nop 1
    v_max_u32_dpp v229, v229, v229 row_bcast:15 row_mask:0xa bank_mask:0xf
L_hpw:
    s_sleep 2
    ds_read_b128 v[232:235], v217 offset:0
    s_add_u32 s71, s71, 1
    s_waitcnt lgkmcnt(0)
    v_min3_u32 v232, v232, v233, v234
    v_min3_u32 v232, v232, v235, v229
    s_cmp_gt_u32 s71, 0x100000
    v_readlane_b32 s35, v232, 31
    s_cbranch_scc1 L_end
    s_sub_u32 s35, s35, 1
    s_cbranch_scc1 L_hpw
    v_subrev_u32 v206, s35, v206
    v_max_i32 v206, 0, v206
    s_mul_i32 s47, s35, 17
    v_mov_b32 v205, v206
    s_nop 1
    v_add_u32_dpp v205, v205, v205 row_shr:4 row_mask:0xf bank_mask:0xf bound_ctrl:0
    s_nop 1
    v_add_u32_dpp v205, v205, v205 row_shr:8 row_mask:0xf bank_mask:0xf bound_ctrl:0
    s_nop 1
    v_add_u32_dpp v205, v205, v205 row_bcast:15 row_mask:0xa bank_mask:0xf
    s_nop 0
    v_readlane_b32 s48, v205, 31
    v_add_u32 v205, s35, v205
    v_sub_u32 v204, v205, v206
    s_lshl_b32 s46, s48, 4
    s_add_u32 s46, s46, s47
    s_lshl_b32 s43, s51, 2
    v_readlane_b32 s36, v204, s43
    v_readlane_b32 s37, v205, s43
    v_cmp_gt_u32 vcc, s74, v222
    v_and_b32 v231, 1, v222
    v_mul_i32_i24 v231, s73, v231
    v_lshl_add_u32 v228, v222, 7, v231
    v_mul_u32_u24 v228, s46, v228
    v_mul_hi_u32 v228, s70, v228
    v_mul_u32_u24 v231, 15421, v228
    v_subrev_u32 v228, s47, v228
    v_lshrrev_b32 v231, 18, v231
    v_ashrrev_i32 v228, 4, v228
    v_add_u32 v228, s35, v228
    v_max_i32 v228, v228, v231
    v_cndmask_b32 v228, -1, v228, vcc
    v_cmp_ge_u32 s[58:59], 0, v228
    s_bcnt1_i32_b64 s78, s[58:59]
    v_cmp_gt_u32 s[58:59], s35, v228
    s_bcnt1_i32_b64 s79, s[58:59]
    v_cmp_ge_u32 s[58:59], s36, v228
    s_bcnt1_i32_b64 s80, s[58:59]
    v_cmp_gt_u32 s[58:59], s37, v228
    s_bcnt1_i32_b64 s81, s[58:59]
    s_sub_u32 s78, s78, 1
    s_sub_u32 s80, s80, 1
    s_max_i32 s80, s80, s79
    s_sub_i32 s79, s79, s78
    s_max_i32 s79, s79, 0
    s_sub_i32 s81, s81, s80
    s_max_i32 s81, s81, 0
    s_cmp_eq_u32 s36, s37
    s_cselect_b32 s81, 0, s81
    s_add_u32 s81, s81, s79
    s_sub_i32 s80, s80, s79
    v_mov_b32 v96, s78
    v_mov_b32 v97, s80
    v_mov_b32 v98, s79
    v_mov_b32 v99, s81
    ds_write_b128 v217, v[96:99] offset:96
    s_mov_b32 s71, 0
    s_add_u32 s53, s82, 1
    s_and_b32 s53, s53, 0xffffff
    s_max_u32 s53, s53, 1
    s_cmp_lg_u32 s2, 0
    s_cbranch_scc1 L_htag
    v_mov_b32 v225, s53
    s_mov_b64 exec, 1
    global_store_dword v7, v225, s[16:17] sc1
    s_mov_b64 exec, -1
    s_branch L_tagok
L_htag:
    global_load_dword v223, v7, s[16:17] sc1
    s_add_u32 s71, s71, 1
    s_waitcnt vmcnt(0)
    v_readfirstlane_b32 s42, v223
    s_cmp_lg_u32 s42, s82
    s_cbranch_scc1 L_tagok
    s_cmp_eq_u32 s42, 0
    s_cbranch_scc1 L_tagok
    s_sleep 16
    s_cmp_lt_u32 s71, 12
    s_cbranch_scc1 L_htag
    s_mov_b32 s53, s42
L_tagok:
    v_mov_b32 v223, s53
    ds_write_b32 v217, v223 offset:32
L_ltag:
    s_mov_b32 s71, 0
L_wtag:
    ds_read_b32 v223, v217 offset:32
    ds_read_b128 v[20:23], v217 offset:96
    s_add_u32 s71, s71, 1
    s_waitcnt lgkmcnt(0)
    v_readfirstlane_b32 s53, v223
    v_readfirstlane_b32 s81, v23
    s_cmp_gt_u32 s71, 0x40000
    s_cbranch_scc1 L_end
    s_lshl_b32 s72, s53, 8
    s_cbranch_scc1 L_chunk
    s_sleep 8
    s_branch L_wtag
L_chunk:
    v_cmp_gt_u32 vcc, v22, v10
    v_cmp_gt_u32 s[84:85], v23, v10
    v_mov_b32 v40, 0
    v_cndmask_b32 v96, v21, v20, vcc
    v_add_u32 v96, v96, v10
    v_lshl_add_u32 v80, v96, 7, v8
    v_add_u32 v10, 8, v10
    v_mov_b32 v41, 0
    v_mov_b32 v42, 0
    v_mov_b32 v43, 0
    v_cmp_gt_u32 vcc, v22, v10
    v_cmp_gt_u32 s[86:87], v23, v10
    v_mov_b32 v44, 0
    v_cndmask_b32 v96, v21, v20, vcc
    v_add_u32 v96, v96, v10
    v_lshl_add_u32 v81, v96, 7, v8
    v_add_u32 v10, 8, v10
    v_mov_b32 v45, 0
    v_mov_b32 v46, 0
    v_mov_b32 v47, 0
    s_mov_b32 s71, 0
L_hprog:
    ds_read_b32 v96, v6 offset:16
    s_add_u32 s71, s71, 1
    s_waitcnt lgkmcnt(0)
    v_readfirstlane_b32 s42, v96
    s_cmp_gt_u32 s71, 0x40000
    s_cbranch_scc1 L_end
    s_cmp_lg_u32 s42, 0
    s_cbranch_scc1 L_go
    s_sleep 3
    s_branch L_hprog
L_go:
    s_mov_b32 s71, 0
L_sweep:
    s_mov_b64 exec, s[84:85]
    s_cbranch_execz L_sp0
    buffer_load_dwordx4 v[40:43], v80, s[28:31], 0 offen sc1
L_sp0:
    s_mov_b64 exec, s[86:87]
    s_cbranch_execz L_sp1
    buffer_load_dwordx4 v[44:47], v81, s[28:31], 0 offen sc1
L_sp1:
    s_mov_b64 exec, -1
    s_add_u32 s71, s71, 1
    s_cmp_gt_u32 s71, 0x40000
    s_cbranch_scc1 L_end
    s_waitcnt vmcnt(0)
    v_lshlrev_b32 v96, 12, v41
    v_bfi_b32 v96, s50, v40, v96
    v_lshlrev_b32 v96, 8, v96
    v_cmp_eq_u32 s[20:21], s72, v96
    v_lshlrev_b32 v97, 12, v45
    v_bfi_b32 v97, s50, v44, v97
    v_lshlrev_b32 v97, 8, v97
    v_cmp_eq_u32 s[22:23], s72, v97
    s_and_b64 s[58:59], s[84:85], s[20:21]
    s_and_b64 s[60:61], s[86:87], s[22:23]
    s_or_b64 s[58:59], s[58:59], s[60:61]
    s_cbranch_scc0 L_sweep
    v_lshlrev_b32 v60, 20, v43
    v_and_b32 v96, s50, v42
    v_lshl_or_b32 v60, v96, 8, v60
    v_lshlrev_b32 v61, 20, v47
    v_and_b32 v96, s50, v46
    v_lshl_or_b32 v61, v96, 8, v61
    s_andn2_b64 s[84:85], s[84:85], s[20:21]
    s_andn2_b64 s[86:87], s[86:87], s[22:23]
    s_or_b64 s[58:59], s[84:85], s[86:87]
    s_cbranch_scc0 L_got
    s_lshr_b64 s[58:59], s[84:85], 4
    s_or_b64 s[84:85], s[84:85], s[58:59]
    s_lshr_b64 s[58:59], s[84:85], 2
    s_or_b64 s[84:85], s[84:85], s[58:59]
    s_lshr_b64 s[58:59], s[84:85], 1
    s_or_b64 s[84:85], s[84:85], s[58:59]
    s_and_b32 s84, s84, 0x01010101
    s_mul_i32 s84, s84, 0xff
    s_and_b32 s85, s85, 0x01010101
    s_mul_i32 s85, s85, 0xff
    s_lshr_b64 s[58:59], s[86:87], 4
    s_or_b64 s[86:87], s[86:87], s[58:59]
    s_lshr_b64 s[58:59], s[86:87], 2
    s_or_b64 s[86:87], s[86:87], s[58:59]
    s_lshr_b64 s[58:59], s[86:87], 1
    s_or_b64 s[86:87], s[86:87], s[58:59]
    s_and_b32 s86, s86, 0x01010101
    s_mul_i32 s86, s86, 0xff
    s_and_b32 s87, s87, 0x01010101
    s_mul_i32 s87, s87, 0xff
    s_branch L_sweep
L_got:
    v_mov_b32_dpp v65, v60 quad_perm:[0,0,2,2] row_mask:0xf bank_mask:0xf
    v_mov_b32_dpp v66, v61 quad_perm:[0,0,2,2] row_mask:0xf bank_mask:0xf
    v_cndmask_b32 v65, v13, v65, s[20:21]
    v_cndmask_b32 v66, v13, v66, s[22:23]
    v_max3_f32 v96, v90, v65, v66
    v_mov_b32_dpp v70, v60 quad_perm:[1,1,3,3] row_mask:0xf bank_mask:0xf
    v_mov_b32_dpp v71, v61 quad_perm:[1,1,3,3] row_mask:0xf bank_mask:0xf
    v_max_f32_dpp v96, v96, v96 row_ror:8 row_mask:0xf bank_mask:0xf
    v_mov_b32 v97, v96
    s_nop 1
    v_permlane16_swap_b32 v96, v97
    s_nop 0
    v_max_f32 v96, v96, v97
    v_mov_b32 v97, v96
    s_nop 1
    v_permlane32_swap_b32 v96, v97
    s_nop 0
    v_max_f32 v96, v96, v97
    v_sub_f32 v90, v90, v96
    v_sub_f32 v65, v65, v96
    v_sub_f32 v66, v66, v96
    v_exp_f32 v97, v90
    v_exp_f32 v65, v65
    v_exp_f32 v66, v66
    v_mov_b32 v90, v96
    v_mul_f32 v91, v91, v97
    v_fmac_f32 v91, v65, v70
    v_fmac_f32 v91, v66, v71
    v_mul_f32 v92, v92, v97
    v_mul_f32 v93, v93, v97
    v_mul_f32 v94, v94, v97
    v_mul_f32 v95, v95, v97
    v_fmac_f32 v92, v65, v40
    v_fmac_f32 v93, v65, v41
    v_fmac_f32 v94, v65, v42
    v_fmac_f32 v95, v65, v43
    v_fmac_f32 v92, v66, v44
    v_fmac_f32 v93, v66, v45
    v_fmac_f32 v94, v66, v46
    v_fmac_f32 v95, v66, v47
    s_add_u32 s49, s49, 16
    s_cmp_lt_u32 s49, s81
    s_cbranch_scc1 L_chunk
    v_add_f32_dpp v91, v91, v91 row_ror:8 row_mask:0xf bank_mask:0xf
    v_permlane16_swap_b32 v92, v93
    v_permlane16_swap_b32 v94, v95
    v_mov_b32 v96, v91
    v_add_f32 v92, v92, v93
    v_add_f32 v94, v94, v95
    v_permlane16_swap_b32 v91, v96
    s_nop 0
    v_permlane32_swap_b32 v92, v94
    v_add_f32 v91, v91, v96
    v_mov_b32 v96, v91
    v_add_f32 v92, v92, v94
    s_nop 0
    v_permlane32_swap_b32 v91, v96
    v_add_f32_dpp v92, v92, v92 row_ror:8 row_mask:0xf bank_mask:0xf
    v_add_f32 v91, v91, v96
    v_rcp_f32 v91, v91
    s_mov_b32 exec_lo, 0x00ff00ff
    s_mov_b32 exec_hi, 0x00ff00ff
    v_mul_f32 v92, v92, v91
    v_cvt_pk_bf16_f32 v96, v92, v92
    global_store_short v16, v96, s[14:15]
    s_xor_b32 s42, s32, 1
    s_or_b32 s42, s2, s42
    s_cbranch_scc1 L_noep
    s_mov_b64 exec, 1
    v_mov_b32 v226, 10485760
    global_store_dword v226, v223, s[18:19]
L_noep:
L_end:
    s_endpgm
.section .rodata,"a"
.p2align 6
.amdhsa_kernel standalone__paged_block_table_kv_radixattention__sampling_kernel
  .amdhsa_next_free_vgpr 248
  .amdhsa_next_free_sgpr 96
  .amdhsa_accum_offset 248
  .amdhsa_group_segment_fixed_size 0
  .amdhsa_kernarg_size 64
  .amdhsa_user_sgpr_count 2
  .amdhsa_user_sgpr_kernarg_segment_ptr 1
  .amdhsa_system_sgpr_workgroup_id_x 1
.end_amdhsa_kernel
```
